```python
import torch

def _softmax(x, axis=-1):
    return torch.softmax(x, dim=axis)
def _gelu(x):
    return torch.nn.functional.gelu(x, approximate="tanh")
def _silu(x):
    return torch.nn.functional.silu(x)
def _sigmoid(x):
    return torch.sigmoid(x)
def _layernorm(x, axis=-1, eps=1e-5):
    m = x.mean(dim=axis, keepdim=True)
    v = x.var(dim=axis, keepdim=True, unbiased=False)
    return (x - m) / torch.sqrt(v + eps)
def _scatter_add(tgt, idx, src, axis=0):
    return tgt.clone().index_add_(axis, idx, src)
def _segment_sum(src, seg, n):
    out = torch.zeros((n,) + src.shape[1:], dtype=src.dtype)
    return out.index_add_(0, seg, src)
def _pad(x, pw):
    flat = tuple(v for pair in reversed(pw) for v in pair)
    return torch.nn.functional.pad(x, flat)

kernel_name = 'standalone__sliding_block_cached__decode'

def setup_inputs():

    _w = (lambda a: (lambda t: t.to(torch.bfloat16) if t.is_floating_point() else t)(torch.as_tensor(a)))
    B, Sq, D = 2, 1, 640
    Hq, Hkv, Sk, Dh = 32, 32, 4096, 128
    assert Hq % Hkv == 0, (Hq, Hkv)
    return {
        "x": _w((lambda *s: torch.randn(*s, dtype=torch.bfloat16) * 0.8)(B, Sq, D)),
        "k_cache": _w((lambda *s: torch.randn(*s, dtype=torch.bfloat16) * 0.8)(B, Hkv, Sk, Dh)),
        "v_cache": _w((lambda *s: torch.randn(*s, dtype=torch.bfloat16) * 0.05)(B, Hkv, Sk, Dh)),
        "wq": _w((lambda *s: torch.randn(*s, dtype=torch.bfloat16) * 0.8)(D, Hq * Dh) * (D ** -0.5)),
        "wo": _w((lambda *s: torch.randn(*s, dtype=torch.bfloat16) * 0.05)(Hq * Dh, D) * ((Hq * Dh) ** -0.5)),
    }

def reference(x, k_cache, v_cache, wq, wo):
    B, Sq, D = x.shape
    Hq, Dh = 32, 128
    Hkv, Sk = k_cache.shape[1], k_cache.shape[2]
    W = min(4096, max(256, Sk // 4))
    rep = Hq // Hkv
    q = (lambda x, *d: x.permute(*d))((x @ wq).reshape(B, Sq, Hq, Dh), 0, 2, 1, 3)
    k = (lambda x, n, axis: torch.repeat_interleave(x, n, dim=axis))(k_cache[:, :, Sk - W:, :], rep, axis=1)
    v = (lambda x, n, axis: torch.repeat_interleave(x, n, dim=axis))(v_cache[:, :, Sk - W:, :], rep, axis=1)
    scores = torch.einsum("bhqd,bhkd->bhqk", q, k) * (Dh ** -0.5)
    p = _softmax(scores, axis=-1)
    o = torch.einsum("bhqk,bhkd->bhqd", p, v)
    return (lambda x, *d: x.permute(*d))(o, 0, 2, 1, 3).reshape(B, Sq, Hq * Dh) @ wo
```

```asm
; @launch grid=(256,1,1) block=(576,1,1) lds=18944
.amdgcn_target "amdgcn-amd-amdhsa--gfx950"
.text
.globl standalone__sliding_block_cached__decode_kernel
.p2align 8
.type standalone__sliding_block_cached__decode_kernel,@function
standalone__sliding_block_cached__decode_kernel:
    s_cmp_ge_u32 s2, 256
    s_cbranch_scc1 L_end
    s_load_dwordx16 s[4:19], s[0:1], 0
    v_and_b32 v1, 63, v0
    v_lshrrev_b32 v2, 6, v0
    s_and_b32 s3, s2, 7
    v_readfirstlane_b32 s59, v2
    s_lshr_b32 s57, s2, 3
    s_lshr_b32 s58, s57, 3
    s_lshl_b32 s52, s3, 2
    s_add_u32 s52, s52, s58
    s_and_b32 s53, s57, 7
    s_lshr_b32 s54, s53, 2
    s_and_b32 s55, s53, 3
    v_lshrrev_b32 v3, 4, v1
    v_and_b32 v4, 15, v1
    s_waitcnt lgkmcnt(0)
    s_mov_b32 s36, s4
    s_and_b32 s37, s5, 0xffff
    s_mov_b32 s38, 0xa00
    s_mov_b32 s39, 0x00020000
    s_mov_b32 s20, s6
    s_and_b32 s21, s7, 0xffff
    s_mov_b32 s22, 0x4000000
    s_mov_b32 s23, 0x00020000
    s_mov_b32 s24, s8
    s_and_b32 s25, s9, 0xffff
    s_mov_b32 s26, 0x4000000
    s_mov_b32 s27, 0x00020000
    s_mov_b32 s28, s10
    s_and_b32 s29, s11, 0xffff
    s_mov_b32 s30, 0x500000
    s_mov_b32 s31, 0x00020000
    s_mov_b32 s32, s12
    s_and_b32 s33, s13, 0xffff
    s_mov_b32 s34, 0x500000
    s_mov_b32 s35, 0x00020000
    s_mov_b32 s44, s14
    s_and_b32 s45, s15, 0xffff
    s_mov_b32 s46, 0xa00
    s_mov_b32 s47, 0x00020000
    s_mov_b32 s48, s16
    s_and_b32 s49, s17, 0xffff
    s_mov_b32 s50, 0x100
    s_mov_b32 s51, 0x00020000
    s_mov_b32 s40, s18
    s_and_b32 s41, s19, 0xffff
    s_mov_b32 s42, 0x180000
    s_mov_b32 s43, 0x00020000
    s_cmp_eq_u32 s59, 8
    s_cbranch_scc1 L_control
    s_mul_i32 s60, s53, 80
    s_lshl_b32 s61, s59, 2
    s_add_u32 s60, s60, s61
    v_add_u32 v5, s60, v3
    v_lshlrev_b32 v6, 13, v5
    v_lshl_add_u32 v6, v4, 4, v6
    s_lshl_b32 s62, s52, 8
    v_add_u32 v6, s62, v6
    v_add_u32 v7, 0x40000, v6
    s_mov_b32 s63, 0x80000
    s_cmp_lt_u32 s59, 4
    s_cselect_b32 s63, s63, 0x7f000000
    v_add_u32 v8, s63, v6
    buffer_load_dwordx4 v[128:131], v6, s[28:31], 0 offen nt
    buffer_load_dwordx4 v[132:135], v7, s[28:31], 0 offen nt
    buffer_load_dwordx4 v[136:139], v8, s[28:31], 0 offen nt
    s_lshl_b32 s61, s60, 1
    s_add_u32 s62, s61, 0
    s_load_dwordx2 s[88:89], s[4:5], s62
    s_add_u32 s62, s61, 1280
    s_load_dwordx2 s[90:91], s[4:5], s62
    s_add_u32 s62, s61, 64
    s_load_dwordx2 s[92:93], s[4:5], s62
    s_add_u32 s62, s61, 1344
    s_load_dwordx2 s[94:95], s[4:5], s62
    s_add_u32 s62, s61, 128
    s_cmp_lt_u32 s59, 4
    s_cselect_b32 s62, s62, s61
    s_load_dwordx2 s[96:97], s[4:5], s62
    s_add_u32 s62, s61, 1408
    s_cmp_lt_u32 s59, 4
    s_cselect_b32 s62, s62, s61
    s_load_dwordx2 s[98:99], s[4:5], s62
    s_lshl_b32 s65, s54, 25
    s_lshl_b32 s66, s52, 20
    s_add_u32 s65, s65, s66
    s_lshl_b32 s66, s55, 16
    s_add_u32 s65, s65, s66
    s_add_u32 s65, s65, 0xc0000
    s_lshl_b32 s66, s59, 13
    s_add_u32 s65, s65, s66
    v_lshlrev_b32 v11, 4, v1
    v_add_u32 v11, s65, v11
    v_add_u32 v12, 0x1000, v11
    s_barrier
    buffer_load_dwordx4 v[16:19], v11, s[20:23], 0 offen offset:0 nt
    buffer_load_dwordx4 v[20:23], v11, s[20:23], 0 offen offset:1024 nt
    buffer_load_dwordx4 v[24:27], v11, s[20:23], 0 offen offset:2048 nt
    buffer_load_dwordx4 v[28:31], v11, s[20:23], 0 offen offset:3072 nt
    v_mov_b32 v13, v3
    v_mov_b32 v14, v4
    s_lshl_b32 s67, s52, 7
    s_lshl_b32 s68, s59, 4
    s_add_u32 s67, s67, s68
    v_lshl_add_u32 v15, v13, 2, s67
    v_mul_u32_u24 v15, 1280, v15
    v_lshl_add_u32 v15, v14, 4, v15
    s_mul_i32 s68, s53, 160
    v_add_u32 v15, s68, v15
    s_mov_b32 s70, 0x03ff03ff
    s_mov_b32 s71, 0x03ff03ff
    v_mov_b32 v96, 0
    v_mov_b32 v97, 0
    v_mov_b32 v98, 0
    v_mov_b32 v99, 0
    v_mov_b32 v100, 0
    v_mov_b32 v101, 0
    v_mov_b32 v102, 0
    v_mov_b32 v103, 0
    v_mov_b32 v104, 0
    v_mov_b32 v105, 0
    v_mov_b32 v106, 0
    v_mov_b32 v107, 0
    v_mov_b32 v108, 0
    v_mov_b32 v109, 0
    v_mov_b32 v110, 0
    v_mov_b32 v111, 0
    v_and_b32 v6, 1, v3
    v_lshlrev_b32 v6, 4, v6
    v_cmp_gt_u32 vcc, 2, v3
    s_waitcnt lgkmcnt(0)
    s_cmp_lt_u32 s59, 4
    s_cselect_b32 s96, s96, 0
    s_cselect_b32 s97, s97, 0
    s_cselect_b32 s98, s98, 0
    s_cselect_b32 s99, s99, 0
    v_mov_b32 v7, s89
    v_mov_b32 v8, s88
    v_cndmask_b32 v7, v7, v8, vcc
    v_lshrrev_b32 v7, v6, v7
    v_and_b32 v140, 0xffff, v7
    v_lshlrev_b32 v146, 16, v7
    v_mov_b32 v7, s91
    v_mov_b32 v8, s90
    v_cndmask_b32 v7, v7, v8, vcc
    v_lshrrev_b32 v7, v6, v7
    v_and_b32 v141, 0xffff, v7
    v_lshlrev_b32 v147, 16, v7
    v_mov_b32 v7, s93
    v_mov_b32 v8, s92
    v_cndmask_b32 v7, v7, v8, vcc
    v_lshrrev_b32 v7, v6, v7
    v_and_b32 v142, 0xffff, v7
    v_lshlrev_b32 v148, 16, v7
    v_mov_b32 v7, s95
    v_mov_b32 v8, s94
    v_cndmask_b32 v7, v7, v8, vcc
    v_lshrrev_b32 v7, v6, v7
    v_and_b32 v143, 0xffff, v7
    v_lshlrev_b32 v149, 16, v7
    v_mov_b32 v7, s97
    v_mov_b32 v8, s96
    v_cndmask_b32 v7, v7, v8, vcc
    v_lshrrev_b32 v7, v6, v7
    v_and_b32 v144, 0xffff, v7
    v_lshlrev_b32 v150, 16, v7
    v_mov_b32 v7, s99
    v_mov_b32 v8, s98
    v_cndmask_b32 v7, v7, v8, vcc
    v_lshrrev_b32 v7, v6, v7
    v_and_b32 v145, 0xffff, v7
    v_lshlrev_b32 v151, 16, v7
    s_waitcnt vmcnt(4)
    v_dot2c_f32_bf16 v96, v128, v140
    v_dot2c_f32_bf16 v97, v128, v146
    v_dot2c_f32_bf16 v98, v129, v140
    v_dot2c_f32_bf16 v99, v129, v146
    v_dot2c_f32_bf16 v100, v130, v140
    v_dot2c_f32_bf16 v101, v130, v146
    v_dot2c_f32_bf16 v102, v131, v140
    v_dot2c_f32_bf16 v103, v131, v146
    v_dot2c_f32_bf16 v104, v128, v141
    v_dot2c_f32_bf16 v105, v128, v147
    v_dot2c_f32_bf16 v106, v129, v141
    v_dot2c_f32_bf16 v107, v129, v147
    v_dot2c_f32_bf16 v108, v130, v141
    v_dot2c_f32_bf16 v109, v130, v147
    v_dot2c_f32_bf16 v110, v131, v141
    v_dot2c_f32_bf16 v111, v131, v147
    v_dot2c_f32_bf16 v96, v132, v142
    v_dot2c_f32_bf16 v97, v132, v148
    v_dot2c_f32_bf16 v98, v133, v142
    v_dot2c_f32_bf16 v99, v133, v148
    v_dot2c_f32_bf16 v100, v134, v142
    v_dot2c_f32_bf16 v101, v134, v148
    v_dot2c_f32_bf16 v102, v135, v142
    v_dot2c_f32_bf16 v103, v135, v148
    v_dot2c_f32_bf16 v104, v132, v143
    v_dot2c_f32_bf16 v105, v132, v149
    v_dot2c_f32_bf16 v106, v133, v143
    v_dot2c_f32_bf16 v107, v133, v149
    v_dot2c_f32_bf16 v108, v134, v143
    v_dot2c_f32_bf16 v109, v134, v149
    v_dot2c_f32_bf16 v110, v135, v143
    v_dot2c_f32_bf16 v111, v135, v149
    v_dot2c_f32_bf16 v96, v136, v144
    v_dot2c_f32_bf16 v97, v136, v150
    v_dot2c_f32_bf16 v98, v137, v144
    v_dot2c_f32_bf16 v99, v137, v150
    v_dot2c_f32_bf16 v100, v138, v144
    v_dot2c_f32_bf16 v101, v138, v150
    v_dot2c_f32_bf16 v102, v139, v144
    v_dot2c_f32_bf16 v103, v139, v150
    v_dot2c_f32_bf16 v104, v136, v145
    v_dot2c_f32_bf16 v105, v136, v151
    v_dot2c_f32_bf16 v106, v137, v145
    v_dot2c_f32_bf16 v107, v137, v151
    v_dot2c_f32_bf16 v108, v138, v145
    v_dot2c_f32_bf16 v109, v138, v151
    v_dot2c_f32_bf16 v110, v139, v145
    v_dot2c_f32_bf16 v111, v139, v151
    s_nop 2
    v_permlane32_swap_b32 v96, v104
    v_permlane32_swap_b32 v97, v105
    v_permlane32_swap_b32 v98, v106
    v_permlane32_swap_b32 v99, v107
    v_permlane32_swap_b32 v100, v108
    v_permlane32_swap_b32 v101, v109
    v_permlane32_swap_b32 v102, v110
    v_permlane32_swap_b32 v103, v111
    v_add_f32 v96, v96, v104
    v_add_f32 v97, v97, v105
    v_add_f32 v98, v98, v106
    v_add_f32 v99, v99, v107
    v_add_f32 v100, v100, v108
    v_add_f32 v101, v101, v109
    v_add_f32 v102, v102, v110
    v_add_f32 v103, v103, v111
    v_permlane16_swap_b32 v96, v100
    v_permlane16_swap_b32 v97, v101
    v_permlane16_swap_b32 v98, v102
    v_permlane16_swap_b32 v99, v103
    v_add_f32 v96, v96, v100
    v_add_f32 v97, v97, v101
    v_add_f32 v98, v98, v102
    v_add_f32 v99, v99, v103
    v_lshrrev_b32 v5, 1, v3
    v_lshlrev_b32 v5, 9, v5
    v_lshl_add_u32 v5, v4, 5, v5
    v_and_b32 v6, 1, v3
    v_lshl_add_u32 v5, v6, 4, v5
    s_lshl_b32 s60, s59, 10
    v_add_u32 v5, s60, v5
    ds_write_b128 v5, v[96:99] offset:2560
    s_waitcnt lgkmcnt(0)
    s_barrier
    v_mov_b32 v5, 0
    s_waitcnt vmcnt(2)
    buffer_load_dwordx4 v[32:35], v12, s[20:23], 0 offen offset:0 nt
    s_waitcnt vmcnt(2)
    buffer_load_dwordx4 v[36:39], v12, s[20:23], 0 offen offset:1024 nt
    s_waitcnt vmcnt(2)
    buffer_load_dwordx4 v[40:43], v12, s[20:23], 0 offen offset:2048 nt
    s_waitcnt vmcnt(2)
    buffer_load_dwordx4 v[44:47], v12, s[20:23], 0 offen offset:3072 nt
    s_waitcnt vmcnt(2)
    buffer_load_dwordx4 v[48:51], v11, s[24:27], 0 offen offset:0 nt
    s_waitcnt vmcnt(2)
    buffer_load_dwordx4 v[52:55], v11, s[24:27], 0 offen offset:1024 nt
    s_waitcnt vmcnt(2)
    buffer_load_dwordx4 v[56:59], v11, s[24:27], 0 offen offset:2048 nt
    ds_read_b32 v6, v5 offset:336
    s_waitcnt vmcnt(2)
    s_waitcnt lgkmcnt(0)
    v_readfirstlane_b32 s60, v6
    s_mov_b32 s69, 11
    s_cmp_lg_u32 s60, 0
    s_cbranch_scc1 L_qk
    buffer_load_dwordx4 v[60:63], v11, s[24:27], 0 offen offset:3072 nt
    ds_read_b32 v6, v5 offset:336
    s_waitcnt vmcnt(2)
    s_waitcnt lgkmcnt(0)
    v_readfirstlane_b32 s60, v6
    s_mov_b32 s69, 12
    s_cmp_lg_u32 s60, 0
    s_cbranch_scc1 L_qk
    buffer_load_dwordx4 v[64:67], v12, s[24:27], 0 offen offset:0 nt
    ds_read_b32 v6, v5 offset:336
    s_waitcnt vmcnt(2)
    s_waitcnt lgkmcnt(0)
    v_readfirstlane_b32 s60, v6
    s_mov_b32 s69, 13
    s_cmp_lg_u32 s60, 0
    s_cbranch_scc1 L_qk
    buffer_load_dwordx4 v[68:71], v12, s[24:27], 0 offen offset:1024 nt
    ds_read_b32 v6, v5 offset:336
    s_waitcnt vmcnt(2)
    s_waitcnt lgkmcnt(0)
    v_readfirstlane_b32 s60, v6
    s_mov_b32 s69, 14
    s_cmp_lg_u32 s60, 0
    s_cbranch_scc1 L_qk
    buffer_load_dwordx4 v[72:75], v12, s[24:27], 0 offen offset:2048 nt
    ds_read_b32 v6, v5 offset:336
    s_waitcnt vmcnt(2)
    s_waitcnt lgkmcnt(0)
    v_readfirstlane_b32 s60, v6
    s_mov_b32 s69, 15
    s_cmp_lg_u32 s60, 0
    s_cbranch_scc1 L_qk
    buffer_load_dwordx4 v[76:79], v12, s[24:27], 0 offen offset:3072 nt
    ds_read_b32 v6, v5 offset:336
    s_waitcnt vmcnt(2)
    s_waitcnt lgkmcnt(0)
    v_readfirstlane_b32 s60, v6
    s_mov_b32 s69, 16
    s_cmp_lg_u32 s60, 0
    s_cbranch_scc1 L_qk
    s_mov_b64 exec, s[70:71]
    buffer_load_dwordx4 v[80:83], v15, s[32:35], 0 offen offset:0 nt
    s_mov_b64 exec, -1
    ds_read_b32 v6, v5 offset:336
    s_waitcnt vmcnt(2)
    s_waitcnt lgkmcnt(0)
    v_readfirstlane_b32 s60, v6
    s_mov_b32 s69, 17
    s_cmp_lg_u32 s60, 0
    s_cbranch_scc1 L_qk
    s_mov_b64 exec, s[70:71]
    buffer_load_dwordx4 v[84:87], v15, s[32:35], 0 offen offset:1280 nt
    s_mov_b64 exec, -1
    ds_read_b32 v6, v5 offset:336
    s_waitcnt vmcnt(2)
    s_waitcnt lgkmcnt(0)
    v_readfirstlane_b32 s60, v6
    s_mov_b32 s69, 18
    s_cmp_lg_u32 s60, 0
    s_cbranch_scc1 L_qk
    s_mov_b64 exec, s[70:71]
    buffer_load_dwordx4 v[88:91], v15, s[32:35], 0 offen offset:2560 nt
    s_mov_b64 exec, -1
    ds_read_b32 v6, v5 offset:336
    s_waitcnt vmcnt(2)
    s_waitcnt lgkmcnt(0)
    v_readfirstlane_b32 s60, v6
    s_mov_b32 s69, 19
    s_cmp_lg_u32 s60, 0
    s_cbranch_scc1 L_qk
    s_mov_b64 exec, s[70:71]
    buffer_load_dwordx4 v[92:95], v15, s[32:35], 0 offen offset:3840 nt
    s_mov_b64 exec, -1
    s_mov_b32 s69, 20
    s_mov_b32 s64, 0
L_waitq:
    ds_read_b32 v6, v5 offset:336
    s_waitcnt lgkmcnt(0)
    v_cmp_eq_u32 s[74:75], 0, v6
    s_add_u32 s64, s64, 1
    s_cmp_eq_u64 s[74:75], 0
    s_cbranch_scc1 L_waitq_done
    s_cmp_ge_u32 s64, 200000
    s_cbranch_scc1 L_waitq_done
    s_sleep 1
    s_branch L_waitq
L_waitq_done:
L_qk:
    v_lshlrev_b32 v5, 4, v4
    ds_read_b128 v[120:123], v5 offset:0
    v_mov_b32 v5, 0
    ds_read_b64 v[152:153], v5 offset:320
    v_mov_b32 v112, 0
    v_mov_b32 v113, 0
    v_mov_b32 v114, 0
    v_mov_b32 v115, 0
    v_mov_b32 v116, 0
    v_mov_b32 v117, 0
    v_mov_b32 v118, 0
    v_mov_b32 v119, 0
    s_waitcnt lgkmcnt(0)
    v_dot2c_f32_bf16 v112, v16, v120
    v_dot2c_f32_bf16 v112, v17, v121
    v_dot2c_f32_bf16 v112, v18, v122
    v_dot2c_f32_bf16 v112, v19, v123
    v_dot2c_f32_bf16 v113, v20, v120
    v_dot2c_f32_bf16 v113, v21, v121
    v_dot2c_f32_bf16 v113, v22, v122
    v_dot2c_f32_bf16 v113, v23, v123
    v_dot2c_f32_bf16 v114, v24, v120
    v_dot2c_f32_bf16 v114, v25, v121
    v_dot2c_f32_bf16 v114, v26, v122
    v_dot2c_f32_bf16 v114, v27, v123
    v_dot2c_f32_bf16 v115, v28, v120
    v_dot2c_f32_bf16 v115, v29, v121
    v_dot2c_f32_bf16 v115, v30, v122
    v_dot2c_f32_bf16 v115, v31, v123
    v_dot2c_f32_bf16 v116, v32, v120
    v_dot2c_f32_bf16 v116, v33, v121
    v_dot2c_f32_bf16 v116, v34, v122
    v_dot2c_f32_bf16 v116, v35, v123
    v_dot2c_f32_bf16 v117, v36, v120
    v_dot2c_f32_bf16 v117, v37, v121
    v_dot2c_f32_bf16 v117, v38, v122
    v_dot2c_f32_bf16 v117, v39, v123
    v_dot2c_f32_bf16 v118, v40, v120
    v_dot2c_f32_bf16 v118, v41, v121
    v_dot2c_f32_bf16 v118, v42, v122
    v_dot2c_f32_bf16 v118, v43, v123
    v_dot2c_f32_bf16 v119, v44, v120
    v_dot2c_f32_bf16 v119, v45, v121
    v_dot2c_f32_bf16 v119, v46, v122
    v_dot2c_f32_bf16 v119, v47, v123
    s_nop 2
    v_add_f32_dpp v112, v112, v112 row_ror:8 row_mask:0xf bank_mask:0xf
    v_add_f32_dpp v113, v113, v113 row_ror:8 row_mask:0xf bank_mask:0xf
    v_add_f32_dpp v114, v114, v114 row_ror:8 row_mask:0xf bank_mask:0xf
    v_add_f32_dpp v115, v115, v115 row_ror:8 row_mask:0xf bank_mask:0xf
    v_add_f32_dpp v116, v116, v116 row_ror:8 row_mask:0xf bank_mask:0xf
    v_add_f32_dpp v117, v117, v117 row_ror:8 row_mask:0xf bank_mask:0xf
    v_add_f32_dpp v118, v118, v118 row_ror:8 row_mask:0xf bank_mask:0xf
    v_add_f32_dpp v119, v119, v119 row_ror:8 row_mask:0xf bank_mask:0xf
    v_add_f32_dpp v112, v112, v112 row_ror:4 row_mask:0xf bank_mask:0xf
    v_add_f32_dpp v113, v113, v113 row_ror:4 row_mask:0xf bank_mask:0xf
    v_add_f32_dpp v114, v114, v114 row_ror:4 row_mask:0xf bank_mask:0xf
    v_add_f32_dpp v115, v115, v115 row_ror:4 row_mask:0xf bank_mask:0xf
    v_add_f32_dpp v116, v116, v116 row_ror:4 row_mask:0xf bank_mask:0xf
    v_add_f32_dpp v117, v117, v117 row_ror:4 row_mask:0xf bank_mask:0xf
    v_add_f32_dpp v118, v118, v118 row_ror:4 row_mask:0xf bank_mask:0xf
    v_add_f32_dpp v119, v119, v119 row_ror:4 row_mask:0xf bank_mask:0xf
    v_add_f32_dpp v112, v112, v112 row_ror:2 row_mask:0xf bank_mask:0xf
    v_add_f32_dpp v113, v113, v113 row_ror:2 row_mask:0xf bank_mask:0xf
    v_add_f32_dpp v114, v114, v114 row_ror:2 row_mask:0xf bank_mask:0xf
    v_add_f32_dpp v115, v115, v115 row_ror:2 row_mask:0xf bank_mask:0xf
    v_add_f32_dpp v116, v116, v116 row_ror:2 row_mask:0xf bank_mask:0xf
    v_add_f32_dpp v117, v117, v117 row_ror:2 row_mask:0xf bank_mask:0xf
    v_add_f32_dpp v118, v118, v118 row_ror:2 row_mask:0xf bank_mask:0xf
    v_add_f32_dpp v119, v119, v119 row_ror:2 row_mask:0xf bank_mask:0xf
    v_add_f32_dpp v112, v112, v112 row_ror:1 row_mask:0xf bank_mask:0xf
    v_add_f32_dpp v113, v113, v113 row_ror:1 row_mask:0xf bank_mask:0xf
    v_add_f32_dpp v114, v114, v114 row_ror:1 row_mask:0xf bank_mask:0xf
    v_add_f32_dpp v115, v115, v115 row_ror:1 row_mask:0xf bank_mask:0xf
    v_add_f32_dpp v116, v116, v116 row_ror:1 row_mask:0xf bank_mask:0xf
    v_add_f32_dpp v117, v117, v117 row_ror:1 row_mask:0xf bank_mask:0xf
    v_add_f32_dpp v118, v118, v118 row_ror:1 row_mask:0xf bank_mask:0xf
    v_add_f32_dpp v119, v119, v119 row_ror:1 row_mask:0xf bank_mask:0xf
    s_mov_b32 s60, 0x3e0293ee
    v_mul_f32 v112, s60, v112
    v_mul_f32 v113, s60, v113
    v_mul_f32 v114, s60, v114
    v_mul_f32 v115, s60, v115
    v_mul_f32 v116, s60, v116
    v_mul_f32 v117, s60, v117
    v_mul_f32 v118, s60, v118
    v_mul_f32 v119, s60, v119
    v_max3_f32 v6, v112, v113, v114
    v_max3_f32 v7, v115, v116, v117
    v_max3_f32 v6, v6, v118, v119
    v_max_f32 v6, v6, v7
    s_nop 1
    v_readlane_b32 s60, v6, 0
    v_readlane_b32 s61, v6, 16
    v_readlane_b32 s62, v6, 32
    v_readlane_b32 s63, v6, 48
    s_nop 1
    v_mov_b32 v7, s60
    v_max_f32 v7, s61, v7
    v_max_f32 v7, s62, v7
    v_max_f32 v7, s63, v7
    s_lshl_b32 s60, s59, 2
    v_mov_b32 v5, s60
    ds_write_b32 v5, v7 offset:256
    s_cmp_eq_u32 s69, 11
    s_cbranch_scc1 L_burst11
    s_cmp_eq_u32 s69, 12
    s_cbranch_scc1 L_burst12
    s_cmp_eq_u32 s69, 13
    s_cbranch_scc1 L_burst13
    s_cmp_eq_u32 s69, 14
    s_cbranch_scc1 L_burst14
    s_cmp_eq_u32 s69, 15
    s_cbranch_scc1 L_burst15
    s_cmp_eq_u32 s69, 16
    s_cbranch_scc1 L_burst16
    s_cmp_eq_u32 s69, 17
    s_cbranch_scc1 L_burst17
    s_cmp_eq_u32 s69, 18
    s_cbranch_scc1 L_burst18
    s_cmp_eq_u32 s69, 19
    s_cbranch_scc1 L_burst19
    s_branch L_issued
L_burst11:
    buffer_load_dwordx4 v[60:63], v11, s[24:27], 0 offen offset:3072 nt
L_burst12:
    buffer_load_dwordx4 v[64:67], v12, s[24:27], 0 offen offset:0 nt
L_burst13:
    buffer_load_dwordx4 v[68:71], v12, s[24:27], 0 offen offset:1024 nt
L_burst14:
    buffer_load_dwordx4 v[72:75], v12, s[24:27], 0 offen offset:2048 nt
L_burst15:
    buffer_load_dwordx4 v[76:79], v12, s[24:27], 0 offen offset:3072 nt
L_burst16:
    s_mov_b64 exec, s[70:71]
    buffer_load_dwordx4 v[80:83], v15, s[32:35], 0 offen offset:0 nt
    s_mov_b64 exec, -1
L_burst17:
    s_mov_b64 exec, s[70:71]
    buffer_load_dwordx4 v[84:87], v15, s[32:35], 0 offen offset:1280 nt
    s_mov_b64 exec, -1
L_burst18:
    s_mov_b64 exec, s[70:71]
    buffer_load_dwordx4 v[88:91], v15, s[32:35], 0 offen offset:2560 nt
    s_mov_b64 exec, -1
L_burst19:
    s_mov_b64 exec, s[70:71]
    buffer_load_dwordx4 v[92:95], v15, s[32:35], 0 offen offset:3840 nt
    s_mov_b64 exec, -1
L_issued:
    s_waitcnt lgkmcnt(0)
    s_barrier
    v_mov_b32 v5, 0
    ds_read_b128 v[16:19], v5 offset:256
    ds_read_b128 v[20:23], v5 offset:272
    s_waitcnt lgkmcnt(0)
    v_max3_f32 v10, v16, v17, v18
    v_max3_f32 v6, v19, v20, v21
    v_max3_f32 v10, v10, v22, v23
    v_max_f32 v10, v10, v6
    v_sub_f32 v112, v112, v10
    v_sub_f32 v113, v113, v10
    v_sub_f32 v114, v114, v10
    v_sub_f32 v115, v115, v10
    v_sub_f32 v116, v116, v10
    v_sub_f32 v117, v117, v10
    v_sub_f32 v118, v118, v10
    v_sub_f32 v119, v119, v10
    v_exp_f32 v112, v112
    v_exp_f32 v113, v113
    v_exp_f32 v114, v114
    v_exp_f32 v115, v115
    v_exp_f32 v116, v116
    v_exp_f32 v117, v117
    v_exp_f32 v118, v118
    v_exp_f32 v119, v119
    s_nop 0
    v_cvt_pk_bf16_f32 v32, v112, v113
    v_cvt_pk_bf16_f32 v33, v114, v115
    v_cvt_pk_bf16_f32 v34, v116, v117
    v_cvt_pk_bf16_f32 v35, v118, v119
    v_and_b32 v16, 0xffff, v32
    v_lshlrev_b32 v17, 16, v32
    v_lshrrev_b32 v18, 16, v32
    v_and_b32 v19, 0xffff0000, v32
    v_and_b32 v20, 0xffff, v33
    v_lshlrev_b32 v21, 16, v33
    v_lshrrev_b32 v22, 16, v33
    v_and_b32 v23, 0xffff0000, v33
    v_and_b32 v24, 0xffff, v34
    v_lshlrev_b32 v25, 16, v34
    v_lshrrev_b32 v26, 16, v34
    v_and_b32 v27, 0xffff0000, v34
    v_and_b32 v28, 0xffff, v35
    v_lshlrev_b32 v29, 16, v35
    v_lshrrev_b32 v30, 16, v35
    v_and_b32 v31, 0xffff0000, v35
    v_add_f32 v6, v17, v19
    v_add_f32 v7, v21, v23
    v_add_f32 v8, v25, v27
    v_add_f32 v9, v29, v31
    v_add_f32 v6, v6, v7
    v_add_f32 v8, v8, v9
    v_add_f32 v9, v6, v8
    s_nop 1
    v_readlane_b32 s60, v9, 0
    v_readlane_b32 s61, v9, 16
    v_readlane_b32 s62, v9, 32
    v_readlane_b32 s63, v9, 48
    s_nop 1
    v_mov_b32 v9, s60
    v_add_f32 v9, s61, v9
    v_add_f32 v9, s62, v9
    v_add_f32 v9, s63, v9
    s_lshl_b32 s60, s59, 2
    v_mov_b32 v5, s60
    ds_write_b32 v5, v9 offset:6656
    v_mov_b32 v96, 0
    v_mov_b32 v97, 0
    v_mov_b32 v98, 0
    v_mov_b32 v99, 0
    v_mov_b32 v100, 0
    v_mov_b32 v101, 0
    v_mov_b32 v102, 0
    v_mov_b32 v103, 0
    s_waitcnt vmcnt(11)
    v_dot2c_f32_bf16 v96, v48, v16
    v_dot2c_f32_bf16 v97, v48, v17
    v_dot2c_f32_bf16 v98, v49, v16
    v_dot2c_f32_bf16 v99, v49, v17
    v_dot2c_f32_bf16 v100, v50, v16
    v_dot2c_f32_bf16 v101, v50, v17
    v_dot2c_f32_bf16 v102, v51, v16
    v_dot2c_f32_bf16 v103, v51, v17
    s_waitcnt vmcnt(10)
    v_dot2c_f32_bf16 v96, v52, v18
    v_dot2c_f32_bf16 v97, v52, v19
    v_dot2c_f32_bf16 v98, v53, v18
    v_dot2c_f32_bf16 v99, v53, v19
    v_dot2c_f32_bf16 v100, v54, v18
    v_dot2c_f32_bf16 v101, v54, v19
    v_dot2c_f32_bf16 v102, v55, v18
    v_dot2c_f32_bf16 v103, v55, v19
    s_waitcnt vmcnt(9)
    v_dot2c_f32_bf16 v96, v56, v20
    v_dot2c_f32_bf16 v97, v56, v21
    v_dot2c_f32_bf16 v98, v57, v20
    v_dot2c_f32_bf16 v99, v57, v21
    v_dot2c_f32_bf16 v100, v58, v20
    v_dot2c_f32_bf16 v101, v58, v21
    v_dot2c_f32_bf16 v102, v59, v20
    v_dot2c_f32_bf16 v103, v59, v21
    s_waitcnt vmcnt(8)
    v_dot2c_f32_bf16 v96, v60, v22
    v_dot2c_f32_bf16 v97, v60, v23
    v_dot2c_f32_bf16 v98, v61, v22
    v_dot2c_f32_bf16 v99, v61, v23
    v_dot2c_f32_bf16 v100, v62, v22
    v_dot2c_f32_bf16 v101, v62, v23
    v_dot2c_f32_bf16 v102, v63, v22
    v_dot2c_f32_bf16 v103, v63, v23
    s_waitcnt vmcnt(7)
    v_dot2c_f32_bf16 v96, v64, v24
    v_dot2c_f32_bf16 v97, v64, v25
    v_dot2c_f32_bf16 v98, v65, v24
    v_dot2c_f32_bf16 v99, v65, v25
    v_dot2c_f32_bf16 v100, v66, v24
    v_dot2c_f32_bf16 v101, v66, v25
    v_dot2c_f32_bf16 v102, v67, v24
    v_dot2c_f32_bf16 v103, v67, v25
    s_waitcnt vmcnt(6)
    v_dot2c_f32_bf16 v96, v68, v26
    v_dot2c_f32_bf16 v97, v68, v27
    v_dot2c_f32_bf16 v98, v69, v26
    v_dot2c_f32_bf16 v99, v69, v27
    v_dot2c_f32_bf16 v100, v70, v26
    v_dot2c_f32_bf16 v101, v70, v27
    v_dot2c_f32_bf16 v102, v71, v26
    v_dot2c_f32_bf16 v103, v71, v27
    s_waitcnt vmcnt(5)
    v_dot2c_f32_bf16 v96, v72, v28
    v_dot2c_f32_bf16 v97, v72, v29
    v_dot2c_f32_bf16 v98, v73, v28
    v_dot2c_f32_bf16 v99, v73, v29
    v_dot2c_f32_bf16 v100, v74, v28
    v_dot2c_f32_bf16 v101, v74, v29
    v_dot2c_f32_bf16 v102, v75, v28
    v_dot2c_f32_bf16 v103, v75, v29
    s_waitcnt vmcnt(4)
    v_dot2c_f32_bf16 v96, v76, v30
    v_dot2c_f32_bf16 v97, v76, v31
    v_dot2c_f32_bf16 v98, v77, v30
    v_dot2c_f32_bf16 v99, v77, v31
    v_dot2c_f32_bf16 v100, v78, v30
    v_dot2c_f32_bf16 v101, v78, v31
    v_dot2c_f32_bf16 v102, v79, v30
    v_dot2c_f32_bf16 v103, v79, v31
    s_nop 1
    v_permlane32_swap_b32 v96, v100
    v_permlane32_swap_b32 v97, v101
    v_permlane32_swap_b32 v98, v102
    v_permlane32_swap_b32 v99, v103
    v_add_f32 v96, v96, v100
    v_add_f32 v97, v97, v101
    v_add_f32 v98, v98, v102
    v_add_f32 v99, v99, v103
    s_nop 0
    v_permlane16_swap_b32 v96, v98
    v_permlane16_swap_b32 v97, v99
    v_add_f32 v96, v96, v98
    v_add_f32 v97, v97, v99
    v_lshl_add_u32 v5, v4, 2, v3
    s_lshl_b32 s60, s59, 9
    v_lshl_add_u32 v5, v5, 3, s60
    ds_write_b64 v5, v[96:97] offset:2560
    s_waitcnt lgkmcnt(0)
    s_barrier
    s_cmp_ge_u32 s59, 2
    s_cbranch_scc1 L_wait_o
    s_lshl_b32 s60, s54, 5
    s_add_u32 s60, s60, s52
    s_lshl_b32 s60, s60, 2
    s_add_u32 s60, s60, s55
    s_lshl_b32 s60, s60, 11
    s_add_u32 s60, s60, 524288
    v_lshl_add_u32 v6, v0, 4, s60
    s_cmp_eq_u32 s59, 1
    s_cbranch_scc1 L_pubstats
    v_lshlrev_b32 v5, 3, v1
    ds_read_b64 v[16:17], v5 offset:2560
    ds_read_b64 v[18:19], v5 offset:3072
    ds_read_b64 v[20:21], v5 offset:3584
    ds_read_b64 v[22:23], v5 offset:4096
    ds_read_b64 v[24:25], v5 offset:4608
    ds_read_b64 v[26:27], v5 offset:5120
    ds_read_b64 v[28:29], v5 offset:5632
    ds_read_b64 v[30:31], v5 offset:6144
    s_waitcnt lgkmcnt(0)
    v_add_f32 v16, v16, v24
    v_add_f32 v17, v17, v25
    v_add_f32 v18, v18, v26
    v_add_f32 v19, v19, v27
    v_add_f32 v20, v20, v28
    v_add_f32 v21, v21, v29
    v_add_f32 v22, v22, v30
    v_add_f32 v23, v23, v31
    v_add_f32 v16, v16, v20
    v_add_f32 v17, v17, v21
    v_add_f32 v18, v18, v22
    v_add_f32 v19, v19, v23
    v_add_f32 v16, v16, v18
    v_add_f32 v17, v17, v19
    v_mov_b32 v18, v152
    v_mov_b32 v19, v153
    buffer_store_dwordx4 v[16:19], v6, s[40:43], 0 offen sc1
    s_branch L_wait_o
L_pubstats:
    v_mov_b32 v5, 0
    ds_read_b128 v[20:23], v5 offset:6656
    ds_read_b128 v[24:27], v5 offset:6672
    s_waitcnt lgkmcnt(0)
    v_add_f32 v20, v20, v24
    v_add_f32 v21, v21, v25
    v_add_f32 v22, v22, v26
    v_add_f32 v23, v23, v27
    v_add_f32 v20, v20, v22
    v_add_f32 v21, v21, v23
    v_add_f32 v16, v20, v21
    v_mov_b32 v17, v10
    v_mov_b32 v18, v152
    v_mov_b32 v19, v153
    s_mov_b64 exec, 1
    buffer_store_dwordx4 v[16:19], v6, s[40:43], 0 offen sc1
    s_mov_b64 exec, -1
    s_branch L_wait_o
L_wait_o:
    s_lshl_b32 s60, s59, 7
    v_lshl_add_u32 v5, v13, 5, s60
    v_mov_b32 v96, 0
    v_mov_b32 v97, 0
    v_mov_b32 v98, 0
    v_mov_b32 v99, 0
    v_mov_b32 v100, 0
    v_mov_b32 v101, 0
    v_mov_b32 v102, 0
    v_mov_b32 v103, 0
    v_mov_b32 v104, 0
    v_mov_b32 v105, 0
    v_mov_b32 v106, 0
    v_mov_b32 v107, 0
    v_mov_b32 v108, 0
    v_mov_b32 v109, 0
    v_mov_b32 v110, 0
    v_mov_b32 v111, 0
    v_lshrrev_b32 v8, 1, v3
    v_mul_u32_u24 v8, 320, v8
    v_lshl_add_u32 v8, v4, 5, v8
    v_and_b32 v6, 1, v3
    v_lshl_add_u32 v8, v6, 4, v8
    s_mul_i32 s60, s59, 640
    v_add_u32 v8, s60, v8
    v_lshlrev_b32 v9, 3, v0
    s_lshl_b32 s60, s53, 5
    s_add_u32 s60, s60, s52
    s_lshl_b32 s60, s60, 11
    s_add_u32 s60, s60, 1048576
    v_lshl_add_u32 v7, v0, 4, s60
    s_waitcnt vmcnt(0)
    s_barrier
    s_mov_b64 exec, s[70:71]
    ds_read_b128 v[16:19], v5 offset:512
    ds_read_b128 v[20:23], v5 offset:528
    ds_read_b128 v[24:27], v5 offset:1536
    ds_read_b128 v[28:31], v5 offset:1552
    s_waitcnt lgkmcnt(0)
    v_dot2c_f32_bf16 v96, v80, v16
    v_dot2c_f32_bf16 v97, v80, v17
    v_dot2c_f32_bf16 v98, v81, v16
    v_dot2c_f32_bf16 v99, v81, v17
    v_dot2c_f32_bf16 v100, v82, v16
    v_dot2c_f32_bf16 v101, v82, v17
    v_dot2c_f32_bf16 v102, v83, v16
    v_dot2c_f32_bf16 v103, v83, v17
    v_dot2c_f32_bf16 v104, v80, v24
    v_dot2c_f32_bf16 v105, v80, v25
    v_dot2c_f32_bf16 v106, v81, v24
    v_dot2c_f32_bf16 v107, v81, v25
    v_dot2c_f32_bf16 v108, v82, v24
    v_dot2c_f32_bf16 v109, v82, v25
    v_dot2c_f32_bf16 v110, v83, v24
    v_dot2c_f32_bf16 v111, v83, v25
    v_dot2c_f32_bf16 v96, v84, v18
    v_dot2c_f32_bf16 v97, v84, v19
    v_dot2c_f32_bf16 v98, v85, v18
    v_dot2c_f32_bf16 v99, v85, v19
    v_dot2c_f32_bf16 v100, v86, v18
    v_dot2c_f32_bf16 v101, v86, v19
    v_dot2c_f32_bf16 v102, v87, v18
    v_dot2c_f32_bf16 v103, v87, v19
    v_dot2c_f32_bf16 v104, v84, v26
    v_dot2c_f32_bf16 v105, v84, v27
    v_dot2c_f32_bf16 v106, v85, v26
    v_dot2c_f32_bf16 v107, v85, v27
    v_dot2c_f32_bf16 v108, v86, v26
    v_dot2c_f32_bf16 v109, v86, v27
    v_dot2c_f32_bf16 v110, v87, v26
    v_dot2c_f32_bf16 v111, v87, v27
    v_dot2c_f32_bf16 v96, v88, v20
    v_dot2c_f32_bf16 v97, v88, v21
    v_dot2c_f32_bf16 v98, v89, v20
    v_dot2c_f32_bf16 v99, v89, v21
    v_dot2c_f32_bf16 v100, v90, v20
    v_dot2c_f32_bf16 v101, v90, v21
    v_dot2c_f32_bf16 v102, v91, v20
    v_dot2c_f32_bf16 v103, v91, v21
    v_dot2c_f32_bf16 v104, v88, v28
    v_dot2c_f32_bf16 v105, v88, v29
    v_dot2c_f32_bf16 v106, v89, v28
    v_dot2c_f32_bf16 v107, v89, v29
    v_dot2c_f32_bf16 v108, v90, v28
    v_dot2c_f32_bf16 v109, v90, v29
    v_dot2c_f32_bf16 v110, v91, v28
    v_dot2c_f32_bf16 v111, v91, v29
    v_dot2c_f32_bf16 v96, v92, v22
    v_dot2c_f32_bf16 v97, v92, v23
    v_dot2c_f32_bf16 v98, v93, v22
    v_dot2c_f32_bf16 v99, v93, v23
    v_dot2c_f32_bf16 v100, v94, v22
    v_dot2c_f32_bf16 v101, v94, v23
    v_dot2c_f32_bf16 v102, v95, v22
    v_dot2c_f32_bf16 v103, v95, v23
    v_dot2c_f32_bf16 v104, v92, v30
    v_dot2c_f32_bf16 v105, v92, v31
    v_dot2c_f32_bf16 v106, v93, v30
    v_dot2c_f32_bf16 v107, v93, v31
    v_dot2c_f32_bf16 v108, v94, v30
    v_dot2c_f32_bf16 v109, v94, v31
    v_dot2c_f32_bf16 v110, v95, v30
    v_dot2c_f32_bf16 v111, v95, v31
    s_mov_b64 exec, -1
    s_nop 1
    v_permlane32_swap_b32 v96, v104
    v_permlane32_swap_b32 v97, v105
    v_permlane32_swap_b32 v98, v106
    v_permlane32_swap_b32 v99, v107
    v_permlane32_swap_b32 v100, v108
    v_permlane32_swap_b32 v101, v109
    v_permlane32_swap_b32 v102, v110
    v_permlane32_swap_b32 v103, v111
    v_add_f32 v96, v96, v104
    v_add_f32 v97, v97, v105
    v_add_f32 v98, v98, v106
    v_add_f32 v99, v99, v107
    v_add_f32 v100, v100, v108
    v_add_f32 v101, v101, v109
    v_add_f32 v102, v102, v110
    v_add_f32 v103, v103, v111
    v_permlane16_swap_b32 v96, v100
    v_permlane16_swap_b32 v97, v101
    v_permlane16_swap_b32 v98, v102
    v_permlane16_swap_b32 v99, v103
    v_add_f32 v96, v96, v100
    v_add_f32 v97, v97, v101
    v_add_f32 v98, v98, v102
    v_add_f32 v99, v99, v103
    s_mov_b64 exec, s[70:71]
    ds_write_b128 v8, v[96:99] offset:7168
    s_mov_b64 exec, -1
    s_waitcnt lgkmcnt(0)
    s_barrier
    s_cmp_ge_u32 s59, 2
    s_cbranch_scc1 L_end
    ds_read_b64 v[16:17], v9 offset:7168
    ds_read_b64 v[18:19], v9 offset:7808
    ds_read_b64 v[20:21], v9 offset:8448
    ds_read_b64 v[22:23], v9 offset:9088
    ds_read_b64 v[24:25], v9 offset:9728
    ds_read_b64 v[26:27], v9 offset:10368
    ds_read_b64 v[28:29], v9 offset:11008
    ds_read_b64 v[30:31], v9 offset:11648
    s_waitcnt lgkmcnt(0)
    v_add_f32 v16, v16, v24
    v_add_f32 v17, v17, v25
    v_add_f32 v18, v18, v26
    v_add_f32 v19, v19, v27
    v_add_f32 v20, v20, v28
    v_add_f32 v21, v21, v29
    v_add_f32 v22, v22, v30
    v_add_f32 v23, v23, v31
    v_add_f32 v16, v16, v20
    v_add_f32 v17, v17, v21
    v_add_f32 v18, v18, v22
    v_add_f32 v19, v19, v23
    v_add_f32 v16, v16, v18
    v_add_f32 v17, v17, v19
    v_mov_b32 v18, v152
    v_mov_b32 v19, v153
    v_cmp_gt_u32 vcc, 80, v0
    s_and_saveexec_b64 s[72:73], vcc
    buffer_store_dwordx4 v[16:19], v7, s[40:43], 0 offen sc1
    s_mov_b64 exec, -1
    s_cmp_lg_u32 s59, 0
    s_cbranch_scc1 L_end
    s_cmp_ge_u32 s52, 20
    s_cbranch_scc1 L_end
    s_lshl_b32 s60, s53, 16
    s_add_u32 s60, s60, 1048576
    s_lshl_b32 s61, s52, 6
    s_add_u32 s60, s60, s61
    v_and_b32 v5, 31, v1
    v_lshl_add_u32 v5, v5, 11, s60
    v_lshrrev_b32 v6, 5, v1
    v_lshl_add_u32 v5, v6, 5, v5
    s_mov_b32 s64, 0
L_poll3:
    buffer_load_dwordx4 v[16:19], v5, s[40:43], 0 offen sc1
    buffer_load_dwordx4 v[20:23], v5, s[40:43], 0 offen offset:16 sc1
    s_waitcnt vmcnt(0)
    v_xor_b32 v24, v18, v152
    v_xor_b32 v25, v19, v153
    v_xor_b32 v26, v22, v152
    v_xor_b32 v27, v23, v153
    v_or3_b32 v24, v24, v26, v27
    v_or_b32 v24, v24, v25
    v_cmp_ne_u32 s[74:75], 0, v24
    s_add_u32 s64, s64, 1
    s_cmp_eq_u64 s[74:75], 0
    s_cbranch_scc1 L_poll3_done
    s_cmp_ge_u32 s64, 200000
    s_cbranch_scc1 L_poll3_done
    s_sleep 1
    s_branch L_poll3
L_poll3_done:
    v_mov_b32 v18, v20
    v_mov_b32 v19, v21
    s_nop 1
    v_add_f32_dpp v16, v16, v16 row_ror:8 row_mask:0xf bank_mask:0xf
    v_add_f32_dpp v17, v17, v17 row_ror:8 row_mask:0xf bank_mask:0xf
    v_add_f32_dpp v18, v18, v18 row_ror:8 row_mask:0xf bank_mask:0xf
    v_add_f32_dpp v19, v19, v19 row_ror:8 row_mask:0xf bank_mask:0xf
    v_add_f32_dpp v16, v16, v16 row_ror:4 row_mask:0xf bank_mask:0xf
    v_add_f32_dpp v17, v17, v17 row_ror:4 row_mask:0xf bank_mask:0xf
    v_add_f32_dpp v18, v18, v18 row_ror:4 row_mask:0xf bank_mask:0xf
    v_add_f32_dpp v19, v19, v19 row_ror:4 row_mask:0xf bank_mask:0xf
    v_add_f32_dpp v16, v16, v16 row_ror:2 row_mask:0xf bank_mask:0xf
    v_add_f32_dpp v17, v17, v17 row_ror:2 row_mask:0xf bank_mask:0xf
    v_add_f32_dpp v18, v18, v18 row_ror:2 row_mask:0xf bank_mask:0xf
    v_add_f32_dpp v19, v19, v19 row_ror:2 row_mask:0xf bank_mask:0xf
    v_add_f32_dpp v16, v16, v16 row_ror:1 row_mask:0xf bank_mask:0xf
    v_add_f32_dpp v17, v17, v17 row_ror:1 row_mask:0xf bank_mask:0xf
    v_add_f32_dpp v18, v18, v18 row_ror:1 row_mask:0xf bank_mask:0xf
    v_add_f32_dpp v19, v19, v19 row_ror:1 row_mask:0xf bank_mask:0xf
    v_mov_b32 v20, v16
    v_mov_b32 v21, v17
    v_mov_b32 v22, v18
    v_mov_b32 v23, v19
    s_nop 1
    v_permlane16_swap_b32 v16, v20
    v_permlane16_swap_b32 v17, v21
    v_permlane16_swap_b32 v18, v22
    v_permlane16_swap_b32 v19, v23
    v_add_f32 v16, v16, v20
    v_add_f32 v17, v17, v21
    v_add_f32 v18, v18, v22
    v_add_f32 v19, v19, v23
    v_cvt_pk_bf16_f32 v16, v16, v17
    v_cvt_pk_bf16_f32 v17, v18, v19
    s_lshl_b32 s60, s52, 3
    s_mul_i32 s61, s53, 80
    s_add_u32 s60, s60, s61
    s_add_u32 s61, s60, 560
    s_cmp_ge_u32 s52, 10
    s_cselect_b32 s60, s61, s60
    v_lshl_add_u32 v7, v6, 2, s60
    v_lshlrev_b32 v7, 1, v7
    s_mov_b32 s72, 1
    s_mov_b32 s73, 1
    s_mov_b64 exec, s[72:73]
    buffer_store_dwordx2 v[16:17], v7, s[44:47], 0 offen
    s_mov_b64 exec, -1
    s_branch L_end
L_control:
    v_mov_b32 v8, 0
    s_cmp_lg_u32 s2, 0
    s_cbranch_scc1 L_nononce
    s_memrealtime s[62:63]
    s_waitcnt lgkmcnt(0)
    s_or_b32 s63, s63, 0x80000000
    v_mov_b32 v10, s62
    v_mov_b32 v11, s63
    s_mov_b64 exec, 1
    buffer_store_dwordx2 v[10:11], v8, s[48:51], 0 offen sc1
    s_mov_b64 exec, -1
L_nononce:
    ds_write_b32 v8, v8 offset:336
    s_waitcnt lgkmcnt(0)
    v_lshlrev_b32 v5, 4, v1
    s_barrier
    s_barrier
    buffer_load_dwordx2 v[16:17], v8, s[48:51], 0 offen sc1
    ds_read_b128 v[20:23], v5 offset:2560
    ds_read_b128 v[24:27], v5 offset:3584
    ds_read_b128 v[28:31], v5 offset:4608
    ds_read_b128 v[32:35], v5 offset:5632
    ds_read_b128 v[36:39], v5 offset:6656
    ds_read_b128 v[40:43], v5 offset:7680
    ds_read_b128 v[44:47], v5 offset:8704
    ds_read_b128 v[48:51], v5 offset:9728
    s_waitcnt lgkmcnt(0)
    v_add_f32 v20, v20, v36
    v_add_f32 v21, v21, v37
    v_add_f32 v22, v22, v38
    v_add_f32 v23, v23, v39
    v_add_f32 v24, v24, v40
    v_add_f32 v25, v25, v41
    v_add_f32 v26, v26, v42
    v_add_f32 v27, v27, v43
    v_add_f32 v28, v28, v44
    v_add_f32 v29, v29, v45
    v_add_f32 v30, v30, v46
    v_add_f32 v31, v31, v47
    v_add_f32 v32, v32, v48
    v_add_f32 v33, v33, v49
    v_add_f32 v34, v34, v50
    v_add_f32 v35, v35, v51
    v_add_f32 v20, v20, v28
    v_add_f32 v21, v21, v29
    v_add_f32 v22, v22, v30
    v_add_f32 v23, v23, v31
    v_add_f32 v24, v24, v32
    v_add_f32 v25, v25, v33
    v_add_f32 v26, v26, v34
    v_add_f32 v27, v27, v35
    v_add_f32 v20, v20, v24
    v_add_f32 v21, v21, v25
    v_add_f32 v22, v22, v26
    v_add_f32 v23, v23, v27
    s_mov_b32 s64, 0
    s_branch L_poll0_chk
L_poll0:
    buffer_load_dwordx2 v[16:17], v8, s[48:51], 0 offen sc1
L_poll0_chk:
    s_waitcnt vmcnt(0)
    v_cmp_eq_u32 s[74:75], 0, v17
    s_add_u32 s64, s64, 1
    s_cmp_eq_u64 s[74:75], 0
    s_cbranch_scc1 L_poll0_done
    s_cmp_ge_u32 s64, 200000
    s_cbranch_scc1 L_poll0_done
    s_sleep 2
    s_branch L_poll0
L_poll0_done:
    v_mov_b32 v24, v22
    v_mov_b32 v25, v23
    v_mov_b32 v22, v16
    v_mov_b32 v23, v17
    v_mov_b32 v26, v16
    v_mov_b32 v27, v17
    s_lshl_b32 s60, s52, 3
    s_add_u32 s60, s60, s53
    s_lshl_b32 s60, s60, 11
    v_lshl_add_u32 v6, v1, 5, s60
    buffer_store_dwordx4 v[20:23], v6, s[40:43], 0 offen sc1
    buffer_store_dwordx4 v[24:27], v6, s[40:43], 0 offen offset:16 sc1
    ds_write_b64 v8, v[16:17] offset:320
    s_lshl_b32 s60, s52, 14
    s_lshl_b32 s61, s54, 10
    s_add_u32 s60, s60, s61
    v_lshl_add_u32 v6, v1, 4, s60
    v_lshl_add_u32 v7, v1, 11, s60
    s_mov_b64 s[72:73], exec
    s_mov_b64 exec, 0xff
    s_mov_b32 s64, 0
L_lp1:
    buffer_load_dwordx2 v[70:71], v7, s[40:43], 0 offen offset:8 sc1
    s_waitcnt vmcnt(0)
    v_xor_b32 v70, v70, v16
    v_xor_b32 v71, v71, v17
    v_or_b32 v70, v70, v71
    v_cmp_ne_u32 s[74:75], 0, v70
    s_add_u32 s64, s64, 1
    s_cmp_eq_u64 s[74:75], 0
    s_cbranch_scc1 L_lp1_done
    s_cmp_ge_u32 s64, 200000
    s_cbranch_scc1 L_lp1_done
    s_sleep 1
    s_branch L_lp1
L_lp1_done:
    s_mov_b64 exec, s[72:73]
    s_mov_b32 s64, 0
L_poll1:
    s_mov_b32 s61, 0
    buffer_load_dwordx4 v[32:35], v6, s[40:43], s61 offen offset:0 sc1
    s_mov_b32 s61, 0
    buffer_load_dwordx4 v[36:39], v6, s[40:43], s61 offen offset:2048 sc1
    s_mov_b32 s61, 4096
    buffer_load_dwordx4 v[40:43], v6, s[40:43], s61 offen offset:0 sc1
    s_mov_b32 s61, 4096
    buffer_load_dwordx4 v[44:47], v6, s[40:43], s61 offen offset:2048 sc1
    s_mov_b32 s61, 8192
    buffer_load_dwordx4 v[48:51], v6, s[40:43], s61 offen offset:0 sc1
    s_mov_b32 s61, 8192
    buffer_load_dwordx4 v[52:55], v6, s[40:43], s61 offen offset:2048 sc1
    s_mov_b32 s61, 12288
    buffer_load_dwordx4 v[56:59], v6, s[40:43], s61 offen offset:0 sc1
    s_mov_b32 s61, 12288
    buffer_load_dwordx4 v[60:63], v6, s[40:43], s61 offen offset:2048 sc1
    s_waitcnt vmcnt(0)
    v_xor_b32 v70, v34, v16
    v_xor_b32 v71, v35, v17
    v_xor_b32 v72, v38, v16
    v_xor_b32 v73, v39, v17
    v_or3_b32 v70, v70, v72, v73
    v_xor_b32 v72, v42, v16
    v_xor_b32 v73, v43, v17
    v_or3_b32 v70, v70, v72, v73
    v_xor_b32 v72, v46, v16
    v_xor_b32 v73, v47, v17
    v_or3_b32 v70, v70, v72, v73
    v_xor_b32 v72, v50, v16
    v_xor_b32 v73, v51, v17
    v_or3_b32 v70, v70, v72, v73
    v_xor_b32 v72, v54, v16
    v_xor_b32 v73, v55, v17
    v_or3_b32 v70, v70, v72, v73
    v_xor_b32 v72, v58, v16
    v_xor_b32 v73, v59, v17
    v_or3_b32 v70, v70, v72, v73
    v_xor_b32 v72, v62, v16
    v_xor_b32 v73, v63, v17
    v_or3_b32 v70, v70, v72, v73
    v_or_b32 v70, v70, v71
    v_cmp_ne_u32 s[74:75], 0, v70
    s_add_u32 s64, s64, 1
    s_cmp_eq_u64 s[74:75], 0
    s_cbranch_scc1 L_poll1_done
    s_cmp_ge_u32 s64, 200000
    s_cbranch_scc1 L_poll1_done
    s_sleep 1
    s_branch L_poll1
L_poll1_done:
    v_add_f32 v32, v32, v48
    v_add_f32 v33, v33, v49
    v_add_f32 v36, v36, v52
    v_add_f32 v37, v37, v53
    v_add_f32 v40, v40, v56
    v_add_f32 v41, v41, v57
    v_add_f32 v44, v44, v60
    v_add_f32 v45, v45, v61
    v_add_f32 v32, v32, v40
    v_add_f32 v33, v33, v41
    v_add_f32 v36, v36, v44
    v_add_f32 v37, v37, v45
    v_add_f32 v32, v32, v36
    v_add_f32 v33, v33, v37
    v_cvt_pk_bf16_f32 v20, v32, v33
    v_lshlrev_b32 v6, 2, v1
    ds_write_b32 v6, v20 offset:0
    v_mov_b32 v9, 1
    s_waitcnt lgkmcnt(0)
    ds_write_b32 v8, v9 offset:336
    s_waitcnt lgkmcnt(0)
    v_mov_b32 v152, v16
    v_mov_b32 v153, v17
    s_barrier
    s_barrier
L_poller:
    s_lshl_b32 s60, s52, 13
    s_add_u32 s60, s60, 524288
    v_and_b32 v5, 31, v1
    v_lshl_add_u32 v5, v5, 5, s60
    v_lshrrev_b32 v6, 5, v1
    v_lshlrev_b32 v6, 18, v6
    v_add_u32 v5, v5, v6
    v_add_u32 v6, s60, v6
    v_add_u32 v7, 0x1000, v5
    v_add_u32 v8, 0x1000, v6
    v_lshrrev_b32 v9, 2, v1
    v_lshlrev_b32 v9, 18, v9
    v_and_b32 v2, 3, v1
    v_lshl_add_u32 v9, v2, 11, v9
    v_add_u32 v9, s60, v9
    v_add_u32 v9, 0x400, v9
    s_mov_b64 s[72:73], exec
    s_mov_b64 exec, 0xff
    s_mov_b32 s64, 0
L_lp2:
    buffer_load_dwordx2 v[112:113], v9, s[40:43], 0 offen offset:8 sc1
    s_waitcnt vmcnt(0)
    v_xor_b32 v112, v112, v152
    v_xor_b32 v113, v113, v153
    v_or_b32 v112, v112, v113
    v_cmp_ne_u32 s[74:75], 0, v112
    s_add_u32 s64, s64, 1
    s_cmp_eq_u64 s[74:75], 0
    s_cbranch_scc1 L_lp2_done
    s_cmp_ge_u32 s64, 200000
    s_cbranch_scc1 L_lp2_done
    s_sleep 1
    s_branch L_lp2
L_lp2_done:
    s_mov_b64 exec, s[72:73]
    s_mov_b32 s64, 0
L_poll2:
    buffer_load_dwordx4 v[16:19], v5, s[40:43], 0 offen offset:0 sc1
    buffer_load_dwordx4 v[20:23], v5, s[40:43], 0 offen offset:16 sc1
    buffer_load_dwordx4 v[24:27], v5, s[40:43], 0 offen offset:2048 sc1
    buffer_load_dwordx4 v[28:31], v5, s[40:43], 0 offen offset:2064 sc1
    buffer_load_dwordx4 v[32:35], v7, s[40:43], 0 offen offset:0 sc1
    buffer_load_dwordx4 v[36:39], v7, s[40:43], 0 offen offset:16 sc1
    buffer_load_dwordx4 v[40:43], v7, s[40:43], 0 offen offset:2048 sc1
    buffer_load_dwordx4 v[44:47], v7, s[40:43], 0 offen offset:2064 sc1
    buffer_load_dwordx4 v[48:51], v6, s[40:43], 0 offen offset:1024 sc1
    buffer_load_dwordx4 v[52:55], v6, s[40:43], 0 offen offset:3072 sc1
    buffer_load_dwordx4 v[56:59], v8, s[40:43], 0 offen offset:1024 sc1
    buffer_load_dwordx4 v[60:63], v8, s[40:43], 0 offen offset:3072 sc1
    s_waitcnt vmcnt(0)
    v_xor_b32 v112, v18, v152
    v_xor_b32 v113, v19, v153
    v_xor_b32 v114, v22, v152
    v_xor_b32 v115, v23, v153
    v_or3_b32 v112, v112, v114, v115
    v_xor_b32 v114, v26, v152
    v_xor_b32 v115, v27, v153
    v_or3_b32 v112, v112, v114, v115
    v_xor_b32 v114, v30, v152
    v_xor_b32 v115, v31, v153
    v_or3_b32 v112, v112, v114, v115
    v_xor_b32 v114, v34, v152
    v_xor_b32 v115, v35, v153
    v_or3_b32 v112, v112, v114, v115
    v_xor_b32 v114, v38, v152
    v_xor_b32 v115, v39, v153
    v_or3_b32 v112, v112, v114, v115
    v_xor_b32 v114, v42, v152
    v_xor_b32 v115, v43, v153
    v_or3_b32 v112, v112, v114, v115
    v_xor_b32 v114, v46, v152
    v_xor_b32 v115, v47, v153
    v_or3_b32 v112, v112, v114, v115
    v_xor_b32 v114, v50, v152
    v_xor_b32 v115, v51, v153
    v_or3_b32 v112, v112, v114, v115
    v_xor_b32 v114, v54, v152
    v_xor_b32 v115, v55, v153
    v_or3_b32 v112, v112, v114, v115
    v_xor_b32 v114, v58, v152
    v_xor_b32 v115, v59, v153
    v_or3_b32 v112, v112, v114, v115
    v_xor_b32 v114, v62, v152
    v_xor_b32 v115, v63, v153
    v_or3_b32 v112, v112, v114, v115
    v_or_b32 v112, v112, v113
    v_cmp_ne_u32 s[74:75], 0, v112
    s_add_u32 s64, s64, 1
    s_cmp_eq_u64 s[74:75], 0
    s_cbranch_scc1 L_poll2_done
    s_cmp_ge_u32 s64, 200000
    s_cbranch_scc1 L_poll2_done
    s_sleep 1
    s_branch L_poll2
L_poll2_done:
    v_max3_f32 v9, v49, v53, v57
    v_max_f32 v9, v9, v61
    v_sub_f32 v96, v49, v9
    v_sub_f32 v97, v53, v9
    v_sub_f32 v98, v57, v9
    v_sub_f32 v99, v61, v9
    v_exp_f32 v96, v96
    v_exp_f32 v97, v97
    v_exp_f32 v98, v98
    v_exp_f32 v99, v99
    s_nop 0
    v_mul_f32 v9, v96, v48
    v_fmac_f32 v9, v97, v52
    v_fmac_f32 v9, v98, v56
    v_fmac_f32 v9, v99, v60
    v_rcp_f32 v9, v9
    v_mul_f32 v100, v96, v16
    v_fmac_f32 v100, v97, v24
    v_fmac_f32 v100, v98, v32
    v_fmac_f32 v100, v99, v40
    v_mul_f32 v101, v96, v17
    v_fmac_f32 v101, v97, v25
    v_fmac_f32 v101, v98, v33
    v_fmac_f32 v101, v99, v41
    v_mul_f32 v102, v96, v20
    v_fmac_f32 v102, v97, v28
    v_fmac_f32 v102, v98, v36
    v_fmac_f32 v102, v99, v44
    v_mul_f32 v103, v96, v21
    v_fmac_f32 v103, v97, v29
    v_fmac_f32 v103, v98, v37
    v_fmac_f32 v103, v99, v45
    v_mul_f32 v100, v100, v9
    v_mul_f32 v101, v101, v9
    v_mul_f32 v102, v102, v9
    v_mul_f32 v103, v103, v9
    v_cvt_pk_bf16_f32 v104, v100, v101
    v_cvt_pk_bf16_f32 v105, v102, v103
    v_and_b32 v112, 0xffff, v104
    v_lshlrev_b32 v113, 16, v104
    v_lshrrev_b32 v114, 16, v104
    v_and_b32 v115, 0xffff0000, v104
    v_and_b32 v116, 0xffff, v105
    v_lshlrev_b32 v117, 16, v105
    v_lshrrev_b32 v118, 16, v105
    v_and_b32 v119, 0xffff0000, v105
    v_lshlrev_b32 v5, 5, v1
    ds_write_b128 v5, v[112:115] offset:512
    ds_write_b128 v5, v[116:119] offset:528
    s_waitcnt lgkmcnt(0)
    s_barrier
L_end:
    s_endpgm
.section .rodata,"a"
.p2align 6
.amdhsa_kernel standalone__sliding_block_cached__decode_kernel
  .amdhsa_next_free_vgpr 168
  .amdhsa_next_free_sgpr 102
  .amdhsa_accum_offset 168
  .amdhsa_group_segment_fixed_size 0
  .amdhsa_kernarg_size 64
  .amdhsa_user_sgpr_count 2
  .amdhsa_user_sgpr_kernarg_segment_ptr 1
  .amdhsa_system_sgpr_workgroup_id_x 1
.end_amdhsa_kernel
```
